```python
import torch

def _softmax(x, axis=-1):
    return torch.softmax(x, dim=axis)
def _gelu(x):
    return torch.nn.functional.gelu(x, approximate="tanh")
def _silu(x):
    return torch.nn.functional.silu(x)
def _sigmoid(x):
    return torch.sigmoid(x)
def _layernorm(x, axis=-1, eps=1e-5):
    m = x.mean(dim=axis, keepdim=True)
    v = x.var(dim=axis, keepdim=True, unbiased=False)
    return (x - m) / torch.sqrt(v + eps)
def _scatter_add(tgt, idx, src, axis=0):
    return tgt.clone().index_add_(axis, idx, src)
def _segment_sum(src, seg, n):
    out = torch.zeros((n,) + src.shape[1:], dtype=src.dtype)
    return out.index_add_(0, seg, src)
def _pad(x, pw):
    flat = tuple(v for pair in reversed(pw) for v in pair)
    return torch.nn.functional.pad(x, flat)

kernel_name = 'standalone__kv_cache_quant_int4_int2_kv_with_per_channel_or_per_token_scales__decode'

def setup_inputs():

    _w = (lambda a: (lambda t: t.to(torch.bfloat16) if t.is_floating_point() else t)(torch.as_tensor(a)))
    B = 1
    Sq = 1
    Skv = 16384
    Hq = 32
    Hkv = 8
    Dh = 128
    bits = 3
    G = -1
    if G <= 0 or G >= Skv:
        G = max(1, Skv // 2)
    Skv = (Skv // G) * G
    ngk = Skv // G
    qmax = (1 << bits) - 1
    return {
        "q": _w((lambda *s: torch.randn(*s, dtype=torch.bfloat16) * 1.6)(B, Hq, Sq, Dh)),
        "qk": _w(torch.randint(0, qmax + 1, (B, Hkv, Skv, Dh)).to(torch.int32)),
        "qv": _w(torch.randint(0, qmax + 1, (B, Hkv, Skv, Dh)).to(torch.int32)),
        "k_scales": _w(torch.abs((lambda *s: torch.randn(*s, dtype=torch.bfloat16) * 1.6)(B, Hkv, ngk, Dh)) * 0.05 + 0.02),
        "k_zeros": _w((lambda *s: torch.randn(*s, dtype=torch.bfloat16) * 1.6)(B, Hkv, ngk, Dh) + float(qmax) / 2.0),
        "v_scales": _w(torch.abs((lambda *s: torch.randn(*s, dtype=torch.bfloat16) * 0.05)(B, Hkv, Skv, 1)) * 0.05 + 0.02),
        "v_zeros": _w((lambda *s: torch.randn(*s, dtype=torch.bfloat16) * 0.05)(B, Hkv, Skv, 1) + float(qmax) / 2.0),
    }

def reference(q, qk, qv, k_scales, k_zeros, v_scales, v_zeros):
    B, Hq, Sq, Dh = q.shape
    Hkv, Skv = qk.shape[1], qk.shape[2]
    ngk = k_scales.shape[2]
    G = Skv // ngk
    ks = (lambda x, n, axis: torch.repeat_interleave(x, n, dim=axis))(k_scales, G, axis=2)
    kz = (lambda x, n, axis: torch.repeat_interleave(x, n, dim=axis))(k_zeros, G, axis=2)
    k = ((lambda x, dt: x.to(dt))(qk, q.dtype) - kz) * ks
    v = ((lambda x, dt: x.to(dt))(qv, q.dtype) - v_zeros) * v_scales
    rep = Hq // Hkv
    if rep > 1:
        k = (lambda x, n, axis: torch.repeat_interleave(x, n, dim=axis))(k, rep, axis=1)
        v = (lambda x, n, axis: torch.repeat_interleave(x, n, dim=axis))(v, rep, axis=1)
    scale = float(Dh) ** -0.5
    logits = torch.einsum("bhqd,bhkd->bhqk", q, k) * scale
    p = _softmax(logits, axis=-1)
    o = torch.einsum("bhqk,bhkd->bhqd", p, v)
    return o
```

```asm
; @launch grid=(256,1,1) block=(512,1,1) lds=16896
.amdgcn_target "amdgcn-amd-amdhsa--gfx950"
.text
.globl standalone__kv_cache_quant_int4_int2_kv_with_per_channel_or_per_token_scales__decode_kernel
.p2align 8
.type standalone__kv_cache_quant_int4_int2_kv_with_per_channel_or_per_token_scales__decode_kernel,@function
standalone__kv_cache_quant_int4_int2_kv_with_per_channel_or_per_token_scales__decode_kernel:
s_cmp_ge_u32 s2, 256
s_cbranch_scc1 L_end
s_setprio 1
s_load_dwordx16 s[4:19], s[0:1], 0
s_load_dwordx4 s[20:23], s[0:1], 64
s_and_b32 s3, s2, 7
s_lshl_b32 s3, s3, 5
s_lshr_b32 s2, s2, 3
s_add_u32 s2, s2, s3
v_lshrrev_b32 v1, 6, v0
v_and_b32 v0, 63, v0
v_readfirstlane_b32 s3, v1
v_bfe_u32 v3, v0, 2, 1
v_and_b32 v4, 3, v0
v_lshlrev_b32 v1, 12, v3
v_lshl_add_u32 v1, v4, 9, v1
v_lshrrev_b32 v3, 3, v0
v_lshl_add_u32 v1, v3, 4, v1
s_lshl_b32 s70, s2, 9
s_lshl_b32 s71, s3, 6
s_add_u32 s70, s70, s71
s_lshl_b32 s71, s70, 9
s_lshl_b32 s72, s70, 1
s_mov_b32 s67, 8192
s_mov_b32 s68, 16384
s_mov_b32 s69, 24576
v_lshrrev_b32 v3, 4, v0
v_and_b32 v88, 15, v0
v_lshlrev_b32 v2, 12, v3
v_lshl_add_u32 v2, v88, 4, v2
v_lshlrev_b32 v89, 4, v3
v_lshl_add_u32 v90, v4, 8, v89
v_bfe_i32 v5, v0, 2, 1
v_and_b32 v5, 0xffff0000, v5
s_lshr_b32 s73, s2, 5
s_and_b32 s74, s2, 31
s_mov_b32 s64, 0xffff0000
s_mov_b32 s65, 0x3e0293ee
s_mov_b32 s66, 0x07060302
s_mov_b32 s75, 0x80008000
s_getreg_b32 s76, hwreg(HW_REG_XCC_ID, 0, 4)
s_min_u32 s76, s76, 8
s_waitcnt lgkmcnt(0)
s_add_u32 s24, s6, s71
s_addc_u32 s25, s7, 0
s_mov_b32 s26, 32768
s_mov_b32 s27, 0x20000
buffer_load_dwordx4 v[104:107], v1, s[24:27], 0 offen offset:0 nt
buffer_load_dwordx4 v[108:111], v1, s[24:27], s67 offen offset:0 nt
buffer_load_dwordx4 v[112:115], v1, s[24:27], 0 offen offset:128 nt
buffer_load_dwordx4 v[116:119], v1, s[24:27], s67 offen offset:128 nt
buffer_load_dwordx4 v[120:123], v1, s[24:27], 0 offen offset:256 nt
buffer_load_dwordx4 v[124:127], v1, s[24:27], s67 offen offset:256 nt
buffer_load_dwordx4 v[128:131], v1, s[24:27], 0 offen offset:384 nt
buffer_load_dwordx4 v[132:135], v1, s[24:27], s67 offen offset:384 nt
s_add_u32 s28, s8, s71
s_addc_u32 s29, s9, 0
s_mov_b32 s30, 32768
s_mov_b32 s31, 0x20000
s_add_u32 s44, s14, s72
s_addc_u32 s45, s15, 0
s_mov_b32 s46, 128
s_mov_b32 s47, 0x20000
s_add_u32 s48, s16, s72
s_addc_u32 s49, s17, 0
s_mov_b32 s50, 128
s_mov_b32 s51, 0x20000
s_lshl_b32 s70, s73, 10
s_add_u32 s32, s4, s70
s_addc_u32 s33, s5, 0
s_mov_b32 s34, 1024
s_mov_b32 s35, 0x20000
s_lshr_b32 s70, s2, 4
s_lshl_b32 s70, s70, 8
s_add_u32 s36, s10, s70
s_addc_u32 s37, s11, 0
s_mov_b32 s38, 256
s_mov_b32 s39, 0x20000
s_add_u32 s40, s12, s70
s_addc_u32 s41, s13, 0
s_mov_b32 s42, 256
s_mov_b32 s43, 0x20000
s_lshl_b32 s78, s73, 16
s_lshl_b32 s79, s74, 6
s_add_u32 s78, s78, s79
s_add_u32 s52, s22, s78
s_addc_u32 s53, s23, 0
s_mov_b32 s54, 63552
s_mov_b32 s55, 0x20000
s_lshl_b32 s78, s73, 10
s_lshl_b32 s79, s74, 3
s_add_u32 s78, s78, s79
s_add_u32 s78, s78, 1048576
s_add_u32 s96, s22, s78
s_addc_u32 s97, s23, 0
s_mov_b32 s98, 776
s_mov_b32 s99, 0x20000
s_lshl_b32 s70, s73, 5
s_add_u32 s60, s20, s70
s_addc_u32 s61, s21, 0
s_mov_b32 s62, 12
s_mov_b32 s63, 0x20000
buffer_load_dwordx4 v[40:43], v90, s[32:35], 0 offen offset:0
buffer_load_dwordx4 v[56:59], v89, s[36:39], 0 offen offset:0
buffer_load_dwordx4 v[44:47], v90, s[32:35], 0 offen offset:64
buffer_load_dwordx4 v[60:63], v89, s[36:39], 0 offen offset:64
buffer_load_dwordx4 v[48:51], v90, s[32:35], 0 offen offset:128
buffer_load_dwordx4 v[64:67], v89, s[36:39], 0 offen offset:128
buffer_load_dwordx4 v[52:55], v90, s[32:35], 0 offen offset:192
buffer_load_dwordx4 v[68:71], v89, s[36:39], 0 offen offset:192
buffer_load_dwordx4 v[24:27], v89, s[40:43], 0 offen offset:0
buffer_load_dwordx4 v[28:31], v89, s[40:43], 0 offen offset:64
buffer_load_dwordx4 v[32:35], v89, s[40:43], 0 offen offset:128
buffer_load_dwordx4 v[36:39], v89, s[40:43], 0 offen offset:192
buffer_load_dwordx4 v[72:75], v89, s[44:47], 0 offen offset:0
buffer_load_dwordx4 v[80:83], v89, s[48:51], 0 offen offset:0
buffer_load_dwordx4 v[76:79], v89, s[44:47], 0 offen offset:64
buffer_load_dwordx4 v[84:87], v89, s[48:51], 0 offen offset:64
buffer_load_dwordx4 v[136:139], v1, s[24:27], 0 offen offset:2048 nt
buffer_load_dwordx4 v[140:143], v1, s[24:27], s67 offen offset:2048 nt
buffer_load_dwordx4 v[144:147], v1, s[24:27], 0 offen offset:2176 nt
buffer_load_dwordx4 v[148:151], v1, s[24:27], s67 offen offset:2176 nt
buffer_load_dwordx4 v[152:155], v1, s[24:27], 0 offen offset:2304 nt
buffer_load_dwordx4 v[156:159], v1, s[24:27], s67 offen offset:2304 nt
buffer_load_dwordx4 v[160:163], v1, s[24:27], 0 offen offset:2432 nt
buffer_load_dwordx4 v[164:167], v1, s[24:27], s67 offen offset:2432 nt
buffer_load_dwordx4 v[168:171], v1, s[24:27], s68 offen offset:0 nt
buffer_load_dwordx4 v[172:175], v1, s[24:27], s69 offen offset:0 nt
buffer_load_dwordx4 v[176:179], v1, s[24:27], s68 offen offset:128 nt
buffer_load_dwordx4 v[180:183], v1, s[24:27], s69 offen offset:128 nt
buffer_load_dwordx4 v[184:187], v1, s[24:27], s68 offen offset:256 nt
buffer_load_dwordx4 v[188:191], v1, s[24:27], s69 offen offset:256 nt
buffer_load_dwordx4 v[192:195], v1, s[24:27], s68 offen offset:384 nt
buffer_load_dwordx4 v[196:199], v1, s[24:27], s69 offen offset:384 nt
buffer_load_dwordx4 v[200:203], v1, s[24:27], s68 offen offset:2048 nt
buffer_load_dwordx4 v[204:207], v1, s[24:27], s69 offen offset:2048 nt
buffer_load_dwordx4 v[208:211], v1, s[24:27], s68 offen offset:2176 nt
buffer_load_dwordx4 v[212:215], v1, s[24:27], s69 offen offset:2176 nt
buffer_load_dwordx4 v[216:219], v1, s[24:27], s68 offen offset:2304 nt
buffer_load_dwordx4 v[220:223], v1, s[24:27], s69 offen offset:2304 nt
buffer_load_dwordx4 v[224:227], v1, s[24:27], s68 offen offset:2432 nt
buffer_load_dwordx4 v[228:231], v1, s[24:27], s69 offen offset:2432 nt
s_setprio 0
s_cmp_eq_u32 s3, 1
s_cbranch_scc0 L_noclear3
v_mov_b32 v96, -1
v_mov_b32 v97, -1
v_mov_b32 v98, -1
v_mov_b32 v99, -1
v_lshrrev_b32 v92, 2, v0
v_and_b32 v93, 3, v0
v_lshlrev_b32 v92, 11, v92
v_lshl_add_u32 v92, v93, 4, v92
s_mov_b32 s70, 32768
buffer_store_dwordx4 v[96:99], v92, s[52:55], 0 offen sc1
buffer_store_dwordx4 v[96:99], v92, s[52:55], s70 offen sc1
v_lshlrev_b32 v93, 8, v93
buffer_store_dwordx2 v[96:97], v93, s[96:99], 0 offen sc1
s_and_b32 s70, s76, 3
s_lshl_b32 s70, s70, 3
s_lshl_b32 s70, 1, s70
s_lshr_b32 s71, s76, 2
s_lshl_b32 s71, s71, 2
v_mov_b32 v94, s70
s_waitcnt vmcnt(0)
s_mov_b64 exec, 1
buffer_atomic_add v94, off, s[60:63], s71 sc1
s_mov_b64 exec, -1
L_noclear3:
buffer_load_dwordx4 v[232:235], v2, s[28:31], 0 offen offset:0 nt
buffer_load_dwordx4 v[236:239], v2, s[28:31], 0 offen offset:512 nt
buffer_load_dwordx4 v[240:243], v2, s[28:31], 0 offen offset:1024 nt
buffer_load_dwordx4 v[244:247], v2, s[28:31], 0 offen offset:1536 nt
buffer_load_dwordx4 v[248:251], v2, s[28:31], 0 offen offset:2048 nt
buffer_load_dwordx4 v[252:255], v2, s[28:31], 0 offen offset:2560 nt
s_waitcnt vmcnt(44)
v_lshlrev_b32 v88, 16, v40
v_and_b32 v89, s64, v40
v_lshlrev_b32 v90, 16, v56
v_and_b32 v91, s64, v56
v_lshlrev_b32 v92, 16, v41
v_and_b32 v93, s64, v41
v_lshlrev_b32 v94, 16, v57
v_and_b32 v95, s64, v57
v_mul_f32 v88, v88, v90
v_mul_f32 v89, v89, v91
v_mul_f32 v92, v92, v94
v_mul_f32 v93, v93, v95
v_and_b32 v90, v5, v88
v_and_b32 v91, v5, v89
v_and_b32 v94, v5, v92
v_and_b32 v95, v5, v93
v_sub_f32 v88, v88, v90
v_sub_f32 v89, v89, v91
v_sub_f32 v92, v92, v94
v_sub_f32 v93, v93, v95
v_perm_b32 v8, v89, v88, s66
v_perm_b32 v9, v93, v92, s66
v_lshlrev_b32 v88, 16, v42
v_and_b32 v89, s64, v42
v_lshlrev_b32 v90, 16, v58
v_and_b32 v91, s64, v58
v_lshlrev_b32 v92, 16, v43
v_and_b32 v93, s64, v43
v_lshlrev_b32 v94, 16, v59
v_and_b32 v95, s64, v59
v_mul_f32 v88, v88, v90
v_mul_f32 v89, v89, v91
v_mul_f32 v92, v92, v94
v_mul_f32 v93, v93, v95
v_and_b32 v90, v5, v88
v_and_b32 v91, v5, v89
v_and_b32 v94, v5, v92
v_and_b32 v95, v5, v93
v_sub_f32 v88, v88, v90
v_sub_f32 v89, v89, v91
v_sub_f32 v92, v92, v94
v_sub_f32 v93, v93, v95
v_perm_b32 v10, v89, v88, s66
v_perm_b32 v11, v93, v92, s66
s_waitcnt vmcnt(42)
v_lshlrev_b32 v88, 16, v44
v_and_b32 v89, s64, v44
v_lshlrev_b32 v90, 16, v60
v_and_b32 v91, s64, v60
v_lshlrev_b32 v92, 16, v45
v_and_b32 v93, s64, v45
v_lshlrev_b32 v94, 16, v61
v_and_b32 v95, s64, v61
v_mul_f32 v88, v88, v90
v_mul_f32 v89, v89, v91
v_mul_f32 v92, v92, v94
v_mul_f32 v93, v93, v95
v_and_b32 v90, v5, v88
v_and_b32 v91, v5, v89
v_and_b32 v94, v5, v92
v_and_b32 v95, v5, v93
v_sub_f32 v88, v88, v90
v_sub_f32 v89, v89, v91
v_sub_f32 v92, v92, v94
v_sub_f32 v93, v93, v95
v_perm_b32 v12, v89, v88, s66
v_perm_b32 v13, v93, v92, s66
v_lshlrev_b32 v88, 16, v46
v_and_b32 v89, s64, v46
v_lshlrev_b32 v90, 16, v62
v_and_b32 v91, s64, v62
v_lshlrev_b32 v92, 16, v47
v_and_b32 v93, s64, v47
v_lshlrev_b32 v94, 16, v63
v_and_b32 v95, s64, v63
v_mul_f32 v88, v88, v90
v_mul_f32 v89, v89, v91
v_mul_f32 v92, v92, v94
v_mul_f32 v93, v93, v95
v_and_b32 v90, v5, v88
v_and_b32 v91, v5, v89
v_and_b32 v94, v5, v92
v_and_b32 v95, v5, v93
v_sub_f32 v88, v88, v90
v_sub_f32 v89, v89, v91
v_sub_f32 v92, v92, v94
v_sub_f32 v93, v93, v95
v_perm_b32 v14, v89, v88, s66
v_perm_b32 v15, v93, v92, s66
s_waitcnt vmcnt(40)
v_lshlrev_b32 v88, 16, v48
v_and_b32 v89, s64, v48
v_lshlrev_b32 v90, 16, v64
v_and_b32 v91, s64, v64
v_lshlrev_b32 v92, 16, v49
v_and_b32 v93, s64, v49
v_lshlrev_b32 v94, 16, v65
v_and_b32 v95, s64, v65
v_mul_f32 v88, v88, v90
v_mul_f32 v89, v89, v91
v_mul_f32 v92, v92, v94
v_mul_f32 v93, v93, v95
v_and_b32 v90, v5, v88
v_and_b32 v91, v5, v89
v_and_b32 v94, v5, v92
v_and_b32 v95, v5, v93
v_sub_f32 v88, v88, v90
v_sub_f32 v89, v89, v91
v_sub_f32 v92, v92, v94
v_sub_f32 v93, v93, v95
v_perm_b32 v16, v89, v88, s66
v_perm_b32 v17, v93, v92, s66
v_lshlrev_b32 v88, 16, v50
v_and_b32 v89, s64, v50
v_lshlrev_b32 v90, 16, v66
v_and_b32 v91, s64, v66
v_lshlrev_b32 v92, 16, v51
v_and_b32 v93, s64, v51
v_lshlrev_b32 v94, 16, v67
v_and_b32 v95, s64, v67
v_mul_f32 v88, v88, v90
v_mul_f32 v89, v89, v91
v_mul_f32 v92, v92, v94
v_mul_f32 v93, v93, v95
v_and_b32 v90, v5, v88
v_and_b32 v91, v5, v89
v_and_b32 v94, v5, v92
v_and_b32 v95, v5, v93
v_sub_f32 v88, v88, v90
v_sub_f32 v89, v89, v91
v_sub_f32 v92, v92, v94
v_sub_f32 v93, v93, v95
v_perm_b32 v18, v89, v88, s66
v_perm_b32 v19, v93, v92, s66
s_waitcnt vmcnt(38)
v_lshlrev_b32 v88, 16, v52
v_and_b32 v89, s64, v52
v_lshlrev_b32 v90, 16, v68
v_and_b32 v91, s64, v68
v_lshlrev_b32 v92, 16, v53
v_and_b32 v93, s64, v53
v_lshlrev_b32 v94, 16, v69
v_and_b32 v95, s64, v69
v_mul_f32 v88, v88, v90
v_mul_f32 v89, v89, v91
v_mul_f32 v92, v92, v94
v_mul_f32 v93, v93, v95
v_and_b32 v90, v5, v88
v_and_b32 v91, v5, v89
v_and_b32 v94, v5, v92
v_and_b32 v95, v5, v93
v_sub_f32 v88, v88, v90
v_sub_f32 v89, v89, v91
v_sub_f32 v92, v92, v94
v_sub_f32 v93, v93, v95
v_perm_b32 v20, v89, v88, s66
v_perm_b32 v21, v93, v92, s66
v_lshlrev_b32 v88, 16, v54
v_and_b32 v89, s64, v54
v_lshlrev_b32 v90, 16, v70
v_and_b32 v91, s64, v70
v_lshlrev_b32 v92, 16, v55
v_and_b32 v93, s64, v55
v_lshlrev_b32 v94, 16, v71
v_and_b32 v95, s64, v71
v_mul_f32 v88, v88, v90
v_mul_f32 v89, v89, v91
v_mul_f32 v92, v92, v94
v_mul_f32 v93, v93, v95
v_and_b32 v90, v5, v88
v_and_b32 v91, v5, v89
v_and_b32 v94, v5, v92
v_and_b32 v95, v5, v93
v_sub_f32 v88, v88, v90
v_sub_f32 v89, v89, v91
v_sub_f32 v92, v92, v94
v_sub_f32 v93, v93, v95
v_perm_b32 v22, v89, v88, s66
v_perm_b32 v23, v93, v92, s66
s_waitcnt vmcnt(34)
v_mfma_f32_16x16x32_bf16 v[100:103], v[24:27], v[8:11], 0
v_mfma_f32_16x16x32_bf16 v[100:103], v[28:31], v[12:15], v[100:103]
v_mfma_f32_16x16x32_bf16 v[100:103], v[32:35], v[16:19], v[100:103]
v_mfma_f32_16x16x32_bf16 v[100:103], v[36:39], v[20:23], v[100:103]
v_cvt_f32_i32 v88, v104
v_cvt_f32_i32 v89, v105
v_cvt_f32_i32 v90, v106
v_cvt_f32_i32 v91, v107
v_cvt_f32_i32 v92, v108
v_cvt_f32_i32 v93, v109
v_cvt_f32_i32 v94, v110
v_cvt_f32_i32 v95, v111
v_cvt_f32_i32_dpp v88, v108 row_ror:8 row_mask:0xf bank_mask:0xc
v_cvt_f32_i32_dpp v89, v109 row_ror:8 row_mask:0xf bank_mask:0xc
v_cvt_f32_i32_dpp v90, v110 row_ror:8 row_mask:0xf bank_mask:0xc
v_cvt_f32_i32_dpp v91, v111 row_ror:8 row_mask:0xf bank_mask:0xc
v_cvt_f32_i32_dpp v92, v104 row_ror:8 row_mask:0xf bank_mask:0x3
v_cvt_f32_i32_dpp v93, v105 row_ror:8 row_mask:0xf bank_mask:0x3
v_cvt_f32_i32_dpp v94, v106 row_ror:8 row_mask:0xf bank_mask:0x3
v_cvt_f32_i32_dpp v95, v107 row_ror:8 row_mask:0xf bank_mask:0x3
v_add_f32_dpp v6, v100, v100 row_ror:4 row_mask:0xf bank_mask:0xf
v_cvt_pk_bf16_f32 v96, v88, v89
v_cvt_pk_bf16_f32 v97, v90, v91
v_cvt_pk_bf16_f32 v98, v92, v93
v_cvt_pk_bf16_f32 v99, v94, v95
buffer_load_dwordx4 v[104:107], v2, s[28:31], 0 offen offset:3072 nt
buffer_load_dwordx4 v[108:111], v2, s[28:31], 0 offen offset:3584 nt
v_mfma_f32_16x16x32_bf16 v[24:27], v[96:99], v[8:11], 0
v_cvt_f32_i32 v88, v112
v_cvt_f32_i32 v89, v113
v_cvt_f32_i32 v90, v114
v_cvt_f32_i32 v91, v115
v_cvt_f32_i32 v92, v116
v_cvt_f32_i32 v93, v117
v_cvt_f32_i32 v94, v118
v_cvt_f32_i32 v95, v119
v_cvt_f32_i32_dpp v88, v116 row_ror:8 row_mask:0xf bank_mask:0xc
v_cvt_f32_i32_dpp v89, v117 row_ror:8 row_mask:0xf bank_mask:0xc
v_cvt_f32_i32_dpp v90, v118 row_ror:8 row_mask:0xf bank_mask:0xc
v_cvt_f32_i32_dpp v91, v119 row_ror:8 row_mask:0xf bank_mask:0xc
v_cvt_f32_i32_dpp v92, v112 row_ror:8 row_mask:0xf bank_mask:0x3
v_cvt_f32_i32_dpp v93, v113 row_ror:8 row_mask:0xf bank_mask:0x3
v_cvt_f32_i32_dpp v94, v114 row_ror:8 row_mask:0xf bank_mask:0x3
v_cvt_f32_i32_dpp v95, v115 row_ror:8 row_mask:0xf bank_mask:0x3
v_cvt_pk_bf16_f32 v96, v88, v89
v_cvt_pk_bf16_f32 v97, v90, v91
v_cvt_pk_bf16_f32 v98, v92, v93
v_cvt_pk_bf16_f32 v99, v94, v95
buffer_load_dwordx4 v[112:115], v2, s[28:31], 0 offen offset:256 nt
buffer_load_dwordx4 v[116:119], v2, s[28:31], 0 offen offset:768 nt
v_mfma_f32_16x16x32_bf16 v[24:27], v[96:99], v[12:15], v[24:27]
v_cvt_f32_i32 v88, v120
v_cvt_f32_i32 v89, v121
v_cvt_f32_i32 v90, v122
v_cvt_f32_i32 v91, v123
v_cvt_f32_i32 v92, v124
v_cvt_f32_i32 v93, v125
v_cvt_f32_i32 v94, v126
v_cvt_f32_i32 v95, v127
v_cvt_f32_i32_dpp v88, v124 row_ror:8 row_mask:0xf bank_mask:0xc
v_cvt_f32_i32_dpp v89, v125 row_ror:8 row_mask:0xf bank_mask:0xc
v_cvt_f32_i32_dpp v90, v126 row_ror:8 row_mask:0xf bank_mask:0xc
v_cvt_f32_i32_dpp v91, v127 row_ror:8 row_mask:0xf bank_mask:0xc
v_cvt_f32_i32_dpp v92, v120 row_ror:8 row_mask:0xf bank_mask:0x3
v_cvt_f32_i32_dpp v93, v121 row_ror:8 row_mask:0xf bank_mask:0x3
v_cvt_f32_i32_dpp v94, v122 row_ror:8 row_mask:0xf bank_mask:0x3
v_cvt_f32_i32_dpp v95, v123 row_ror:8 row_mask:0xf bank_mask:0x3
v_cvt_pk_bf16_f32 v96, v88, v89
v_cvt_pk_bf16_f32 v97, v90, v91
v_cvt_pk_bf16_f32 v98, v92, v93
v_cvt_pk_bf16_f32 v99, v94, v95
buffer_load_dwordx4 v[120:123], v2, s[28:31], 0 offen offset:1280 nt
buffer_load_dwordx4 v[124:127], v2, s[28:31], 0 offen offset:1792 nt
v_mfma_f32_16x16x32_bf16 v[24:27], v[96:99], v[16:19], v[24:27]
v_cvt_f32_i32 v88, v128
v_cvt_f32_i32 v89, v129
v_cvt_f32_i32 v90, v130
v_cvt_f32_i32 v91, v131
v_cvt_f32_i32 v92, v132
v_cvt_f32_i32 v93, v133
v_cvt_f32_i32 v94, v134
v_cvt_f32_i32 v95, v135
v_cvt_f32_i32_dpp v88, v132 row_ror:8 row_mask:0xf bank_mask:0xc
v_cvt_f32_i32_dpp v89, v133 row_ror:8 row_mask:0xf bank_mask:0xc
v_cvt_f32_i32_dpp v90, v134 row_ror:8 row_mask:0xf bank_mask:0xc
v_cvt_f32_i32_dpp v91, v135 row_ror:8 row_mask:0xf bank_mask:0xc
v_cvt_f32_i32_dpp v92, v128 row_ror:8 row_mask:0xf bank_mask:0x3
v_cvt_f32_i32_dpp v93, v129 row_ror:8 row_mask:0xf bank_mask:0x3
v_cvt_f32_i32_dpp v94, v130 row_ror:8 row_mask:0xf bank_mask:0x3
v_cvt_f32_i32_dpp v95, v131 row_ror:8 row_mask:0xf bank_mask:0x3
v_cvt_pk_bf16_f32 v96, v88, v89
v_cvt_pk_bf16_f32 v97, v90, v91
v_cvt_pk_bf16_f32 v98, v92, v93
v_cvt_pk_bf16_f32 v99, v94, v95
buffer_load_dwordx4 v[128:131], v2, s[28:31], 0 offen offset:2304 nt
buffer_load_dwordx4 v[132:135], v2, s[28:31], 0 offen offset:2816 nt
v_mfma_f32_16x16x32_bf16 v[24:27], v[96:99], v[20:23], v[24:27]
s_waitcnt vmcnt(36)
v_cvt_f32_i32 v88, v136
v_cvt_f32_i32 v89, v137
v_cvt_f32_i32 v90, v138
v_cvt_f32_i32 v91, v139
v_cvt_f32_i32 v92, v140
v_cvt_f32_i32 v93, v141
v_cvt_f32_i32 v94, v142
v_cvt_f32_i32 v95, v143
v_cvt_f32_i32_dpp v88, v140 row_ror:8 row_mask:0xf bank_mask:0xc
v_cvt_f32_i32_dpp v89, v141 row_ror:8 row_mask:0xf bank_mask:0xc
v_cvt_f32_i32_dpp v90, v142 row_ror:8 row_mask:0xf bank_mask:0xc
v_cvt_f32_i32_dpp v91, v143 row_ror:8 row_mask:0xf bank_mask:0xc
v_cvt_f32_i32_dpp v92, v136 row_ror:8 row_mask:0xf bank_mask:0x3
v_cvt_f32_i32_dpp v93, v137 row_ror:8 row_mask:0xf bank_mask:0x3
v_cvt_f32_i32_dpp v94, v138 row_ror:8 row_mask:0xf bank_mask:0x3
v_cvt_f32_i32_dpp v95, v139 row_ror:8 row_mask:0xf bank_mask:0x3
v_cvt_pk_bf16_f32 v96, v88, v89
v_cvt_pk_bf16_f32 v97, v90, v91
v_cvt_pk_bf16_f32 v98, v92, v93
v_cvt_pk_bf16_f32 v99, v94, v95
buffer_load_dwordx4 v[136:139], v2, s[28:31], 0 offen offset:3328 nt
buffer_load_dwordx4 v[140:143], v2, s[28:31], 0 offen offset:3840 nt
v_mfma_f32_16x16x32_bf16 v[28:31], v[96:99], v[8:11], 0
s_waitcnt vmcnt(36)
v_cvt_f32_i32 v88, v144
v_cvt_f32_i32 v89, v145
v_cvt_f32_i32 v90, v146
v_cvt_f32_i32 v91, v147
v_cvt_f32_i32 v92, v148
v_cvt_f32_i32 v93, v149
v_cvt_f32_i32 v94, v150
v_cvt_f32_i32 v95, v151
v_cvt_f32_i32_dpp v88, v148 row_ror:8 row_mask:0xf bank_mask:0xc
v_cvt_f32_i32_dpp v89, v149 row_ror:8 row_mask:0xf bank_mask:0xc
v_cvt_f32_i32_dpp v90, v150 row_ror:8 row_mask:0xf bank_mask:0xc
v_cvt_f32_i32_dpp v91, v151 row_ror:8 row_mask:0xf bank_mask:0xc
v_cvt_f32_i32_dpp v92, v144 row_ror:8 row_mask:0xf bank_mask:0x3
v_cvt_f32_i32_dpp v93, v145 row_ror:8 row_mask:0xf bank_mask:0x3
v_cvt_f32_i32_dpp v94, v146 row_ror:8 row_mask:0xf bank_mask:0x3
v_cvt_f32_i32_dpp v95, v147 row_ror:8 row_mask:0xf bank_mask:0x3
v_cvt_pk_bf16_f32 v96, v88, v89
v_cvt_pk_bf16_f32 v97, v90, v91
v_cvt_pk_bf16_f32 v98, v92, v93
v_cvt_pk_bf16_f32 v99, v94, v95
buffer_load_dwordx4 v[144:147], v2, s[28:31], s68 offen offset:0 nt
buffer_load_dwordx4 v[148:151], v2, s[28:31], s68 offen offset:512 nt
v_mfma_f32_16x16x32_bf16 v[28:31], v[96:99], v[12:15], v[28:31]
s_waitcnt vmcnt(36)
v_cvt_f32_i32 v88, v152
v_cvt_f32_i32 v89, v153
v_cvt_f32_i32 v90, v154
v_cvt_f32_i32 v91, v155
v_cvt_f32_i32 v92, v156
v_cvt_f32_i32 v93, v157
v_cvt_f32_i32 v94, v158
v_cvt_f32_i32 v95, v159
v_cvt_f32_i32_dpp v88, v156 row_ror:8 row_mask:0xf bank_mask:0xc
v_cvt_f32_i32_dpp v89, v157 row_ror:8 row_mask:0xf bank_mask:0xc
v_cvt_f32_i32_dpp v90, v158 row_ror:8 row_mask:0xf bank_mask:0xc
v_cvt_f32_i32_dpp v91, v159 row_ror:8 row_mask:0xf bank_mask:0xc
v_cvt_f32_i32_dpp v92, v152 row_ror:8 row_mask:0xf bank_mask:0x3
v_cvt_f32_i32_dpp v93, v153 row_ror:8 row_mask:0xf bank_mask:0x3
v_cvt_f32_i32_dpp v94, v154 row_ror:8 row_mask:0xf bank_mask:0x3
v_cvt_f32_i32_dpp v95, v155 row_ror:8 row_mask:0xf bank_mask:0x3
v_cvt_pk_bf16_f32 v96, v88, v89
v_cvt_pk_bf16_f32 v97, v90, v91
v_cvt_pk_bf16_f32 v98, v92, v93
v_cvt_pk_bf16_f32 v99, v94, v95
buffer_load_dwordx4 v[152:155], v2, s[28:31], s68 offen offset:1024 nt
buffer_load_dwordx4 v[156:159], v2, s[28:31], s68 offen offset:1536 nt
v_mfma_f32_16x16x32_bf16 v[28:31], v[96:99], v[16:19], v[28:31]
s_waitcnt vmcnt(36)
v_cvt_f32_i32 v88, v160
v_cvt_f32_i32 v89, v161
v_cvt_f32_i32 v90, v162
v_cvt_f32_i32 v91, v163
v_cvt_f32_i32 v92, v164
v_cvt_f32_i32 v93, v165
v_cvt_f32_i32 v94, v166
v_cvt_f32_i32 v95, v167
v_cvt_f32_i32_dpp v88, v164 row_ror:8 row_mask:0xf bank_mask:0xc
v_cvt_f32_i32_dpp v89, v165 row_ror:8 row_mask:0xf bank_mask:0xc
v_cvt_f32_i32_dpp v90, v166 row_ror:8 row_mask:0xf bank_mask:0xc
v_cvt_f32_i32_dpp v91, v167 row_ror:8 row_mask:0xf bank_mask:0xc
v_cvt_f32_i32_dpp v92, v160 row_ror:8 row_mask:0xf bank_mask:0x3
v_cvt_f32_i32_dpp v93, v161 row_ror:8 row_mask:0xf bank_mask:0x3
v_cvt_f32_i32_dpp v94, v162 row_ror:8 row_mask:0xf bank_mask:0x3
v_cvt_f32_i32_dpp v95, v163 row_ror:8 row_mask:0xf bank_mask:0x3
v_cvt_pk_bf16_f32 v96, v88, v89
v_cvt_pk_bf16_f32 v97, v90, v91
v_cvt_pk_bf16_f32 v98, v92, v93
v_cvt_pk_bf16_f32 v99, v94, v95
buffer_load_dwordx4 v[160:163], v2, s[28:31], s68 offen offset:2048 nt
buffer_load_dwordx4 v[164:167], v2, s[28:31], s68 offen offset:2560 nt
v_mfma_f32_16x16x32_bf16 v[28:31], v[96:99], v[20:23], v[28:31]
s_waitcnt vmcnt(36)
v_cvt_f32_i32 v88, v168
v_cvt_f32_i32 v89, v169
v_cvt_f32_i32 v90, v170
v_cvt_f32_i32 v91, v171
v_cvt_f32_i32 v92, v172
v_cvt_f32_i32 v93, v173
v_cvt_f32_i32 v94, v174
v_cvt_f32_i32 v95, v175
v_cvt_f32_i32_dpp v88, v172 row_ror:8 row_mask:0xf bank_mask:0xc
v_cvt_f32_i32_dpp v89, v173 row_ror:8 row_mask:0xf bank_mask:0xc
v_cvt_f32_i32_dpp v90, v174 row_ror:8 row_mask:0xf bank_mask:0xc
v_cvt_f32_i32_dpp v91, v175 row_ror:8 row_mask:0xf bank_mask:0xc
v_cvt_f32_i32_dpp v92, v168 row_ror:8 row_mask:0xf bank_mask:0x3
v_cvt_f32_i32_dpp v93, v169 row_ror:8 row_mask:0xf bank_mask:0x3
v_cvt_f32_i32_dpp v94, v170 row_ror:8 row_mask:0xf bank_mask:0x3
v_cvt_f32_i32_dpp v95, v171 row_ror:8 row_mask:0xf bank_mask:0x3
v_cvt_pk_bf16_f32 v96, v88, v89
v_cvt_pk_bf16_f32 v97, v90, v91
v_cvt_pk_bf16_f32 v98, v92, v93
v_cvt_pk_bf16_f32 v99, v94, v95
buffer_load_dwordx4 v[168:171], v2, s[28:31], s68 offen offset:3072 nt
buffer_load_dwordx4 v[172:175], v2, s[28:31], s68 offen offset:3584 nt
v_mfma_f32_16x16x32_bf16 v[32:35], v[96:99], v[8:11], 0
s_waitcnt vmcnt(36)
v_cvt_f32_i32 v88, v176
v_cvt_f32_i32 v89, v177
v_cvt_f32_i32 v90, v178
v_cvt_f32_i32 v91, v179
v_cvt_f32_i32 v92, v180
v_cvt_f32_i32 v93, v181
v_cvt_f32_i32 v94, v182
v_cvt_f32_i32 v95, v183
v_cvt_f32_i32_dpp v88, v180 row_ror:8 row_mask:0xf bank_mask:0xc
v_cvt_f32_i32_dpp v89, v181 row_ror:8 row_mask:0xf bank_mask:0xc
v_cvt_f32_i32_dpp v90, v182 row_ror:8 row_mask:0xf bank_mask:0xc
v_cvt_f32_i32_dpp v91, v183 row_ror:8 row_mask:0xf bank_mask:0xc
v_cvt_f32_i32_dpp v92, v176 row_ror:8 row_mask:0xf bank_mask:0x3
v_cvt_f32_i32_dpp v93, v177 row_ror:8 row_mask:0xf bank_mask:0x3
v_cvt_f32_i32_dpp v94, v178 row_ror:8 row_mask:0xf bank_mask:0x3
v_cvt_f32_i32_dpp v95, v179 row_ror:8 row_mask:0xf bank_mask:0x3
v_cvt_pk_bf16_f32 v96, v88, v89
v_cvt_pk_bf16_f32 v97, v90, v91
v_cvt_pk_bf16_f32 v98, v92, v93
v_cvt_pk_bf16_f32 v99, v94, v95
buffer_load_dwordx4 v[176:179], v2, s[28:31], s68 offen offset:256 nt
buffer_load_dwordx4 v[180:183], v2, s[28:31], s68 offen offset:768 nt
v_mfma_f32_16x16x32_bf16 v[32:35], v[96:99], v[12:15], v[32:35]
s_waitcnt vmcnt(36)
v_cvt_f32_i32 v88, v184
v_cvt_f32_i32 v89, v185
v_cvt_f32_i32 v90, v186
v_cvt_f32_i32 v91, v187
v_cvt_f32_i32 v92, v188
v_cvt_f32_i32 v93, v189
v_cvt_f32_i32 v94, v190
v_cvt_f32_i32 v95, v191
v_cvt_f32_i32_dpp v88, v188 row_ror:8 row_mask:0xf bank_mask:0xc
v_cvt_f32_i32_dpp v89, v189 row_ror:8 row_mask:0xf bank_mask:0xc
v_cvt_f32_i32_dpp v90, v190 row_ror:8 row_mask:0xf bank_mask:0xc
v_cvt_f32_i32_dpp v91, v191 row_ror:8 row_mask:0xf bank_mask:0xc
v_cvt_f32_i32_dpp v92, v184 row_ror:8 row_mask:0xf bank_mask:0x3
v_cvt_f32_i32_dpp v93, v185 row_ror:8 row_mask:0xf bank_mask:0x3
v_cvt_f32_i32_dpp v94, v186 row_ror:8 row_mask:0xf bank_mask:0x3
v_cvt_f32_i32_dpp v95, v187 row_ror:8 row_mask:0xf bank_mask:0x3
v_cvt_pk_bf16_f32 v96, v88, v89
v_cvt_pk_bf16_f32 v97, v90, v91
v_cvt_pk_bf16_f32 v98, v92, v93
v_cvt_pk_bf16_f32 v99, v94, v95
buffer_load_dwordx4 v[184:187], v2, s[28:31], s68 offen offset:1280 nt
buffer_load_dwordx4 v[188:191], v2, s[28:31], s68 offen offset:1792 nt
v_mfma_f32_16x16x32_bf16 v[32:35], v[96:99], v[16:19], v[32:35]
s_waitcnt vmcnt(36)
v_cvt_f32_i32 v88, v192
v_cvt_f32_i32 v89, v193
v_cvt_f32_i32 v90, v194
v_cvt_f32_i32 v91, v195
v_cvt_f32_i32 v92, v196
v_cvt_f32_i32 v93, v197
v_cvt_f32_i32 v94, v198
v_cvt_f32_i32 v95, v199
v_cvt_f32_i32_dpp v88, v196 row_ror:8 row_mask:0xf bank_mask:0xc
v_cvt_f32_i32_dpp v89, v197 row_ror:8 row_mask:0xf bank_mask:0xc
v_cvt_f32_i32_dpp v90, v198 row_ror:8 row_mask:0xf bank_mask:0xc
v_cvt_f32_i32_dpp v91, v199 row_ror:8 row_mask:0xf bank_mask:0xc
v_cvt_f32_i32_dpp v92, v192 row_ror:8 row_mask:0xf bank_mask:0x3
v_cvt_f32_i32_dpp v93, v193 row_ror:8 row_mask:0xf bank_mask:0x3
v_cvt_f32_i32_dpp v94, v194 row_ror:8 row_mask:0xf bank_mask:0x3
v_cvt_f32_i32_dpp v95, v195 row_ror:8 row_mask:0xf bank_mask:0x3
v_cvt_pk_bf16_f32 v96, v88, v89
v_cvt_pk_bf16_f32 v97, v90, v91
v_cvt_pk_bf16_f32 v98, v92, v93
v_cvt_pk_bf16_f32 v99, v94, v95
buffer_load_dwordx4 v[192:195], v2, s[28:31], s68 offen offset:2304 nt
buffer_load_dwordx4 v[196:199], v2, s[28:31], s68 offen offset:2816 nt
v_mfma_f32_16x16x32_bf16 v[32:35], v[96:99], v[20:23], v[32:35]
s_waitcnt vmcnt(36)
v_cvt_f32_i32 v88, v200
v_cvt_f32_i32 v89, v201
v_cvt_f32_i32 v90, v202
v_cvt_f32_i32 v91, v203
v_cvt_f32_i32 v92, v204
v_cvt_f32_i32 v93, v205
v_cvt_f32_i32 v94, v206
v_cvt_f32_i32 v95, v207
v_cvt_f32_i32_dpp v88, v204 row_ror:8 row_mask:0xf bank_mask:0xc
v_cvt_f32_i32_dpp v89, v205 row_ror:8 row_mask:0xf bank_mask:0xc
v_cvt_f32_i32_dpp v90, v206 row_ror:8 row_mask:0xf bank_mask:0xc
v_cvt_f32_i32_dpp v91, v207 row_ror:8 row_mask:0xf bank_mask:0xc
v_cvt_f32_i32_dpp v92, v200 row_ror:8 row_mask:0xf bank_mask:0x3
v_cvt_f32_i32_dpp v93, v201 row_ror:8 row_mask:0xf bank_mask:0x3
v_cvt_f32_i32_dpp v94, v202 row_ror:8 row_mask:0xf bank_mask:0x3
v_cvt_f32_i32_dpp v95, v203 row_ror:8 row_mask:0xf bank_mask:0x3
v_cvt_pk_bf16_f32 v96, v88, v89
v_cvt_pk_bf16_f32 v97, v90, v91
v_cvt_pk_bf16_f32 v98, v92, v93
v_cvt_pk_bf16_f32 v99, v94, v95
buffer_load_dwordx4 v[200:203], v2, s[28:31], s68 offen offset:3328 nt
buffer_load_dwordx4 v[204:207], v2, s[28:31], s68 offen offset:3840 nt
v_mfma_f32_16x16x32_bf16 v[36:39], v[96:99], v[8:11], 0
s_waitcnt vmcnt(36)
v_cvt_f32_i32 v88, v208
v_cvt_f32_i32 v89, v209
v_cvt_f32_i32 v90, v210
v_cvt_f32_i32 v91, v211
v_cvt_f32_i32 v92, v212
v_cvt_f32_i32 v93, v213
v_cvt_f32_i32 v94, v214
v_cvt_f32_i32 v95, v215
v_cvt_f32_i32_dpp v88, v212 row_ror:8 row_mask:0xf bank_mask:0xc
v_cvt_f32_i32_dpp v89, v213 row_ror:8 row_mask:0xf bank_mask:0xc
v_cvt_f32_i32_dpp v90, v214 row_ror:8 row_mask:0xf bank_mask:0xc
v_cvt_f32_i32_dpp v91, v215 row_ror:8 row_mask:0xf bank_mask:0xc
v_cvt_f32_i32_dpp v92, v208 row_ror:8 row_mask:0xf bank_mask:0x3
v_cvt_f32_i32_dpp v93, v209 row_ror:8 row_mask:0xf bank_mask:0x3
v_cvt_f32_i32_dpp v94, v210 row_ror:8 row_mask:0xf bank_mask:0x3
v_cvt_f32_i32_dpp v95, v211 row_ror:8 row_mask:0xf bank_mask:0x3
v_cvt_pk_bf16_f32 v96, v88, v89
v_cvt_pk_bf16_f32 v97, v90, v91
v_cvt_pk_bf16_f32 v98, v92, v93
v_cvt_pk_bf16_f32 v99, v94, v95
s_nop 1
v_mfma_f32_16x16x32_bf16 v[36:39], v[96:99], v[12:15], v[36:39]
s_waitcnt vmcnt(34)
v_cvt_f32_i32 v88, v216
v_cvt_f32_i32 v89, v217
v_cvt_f32_i32 v90, v218
v_cvt_f32_i32 v91, v219
v_cvt_f32_i32 v92, v220
v_cvt_f32_i32 v93, v221
v_cvt_f32_i32 v94, v222
v_cvt_f32_i32 v95, v223
v_cvt_f32_i32_dpp v88, v220 row_ror:8 row_mask:0xf bank_mask:0xc
v_cvt_f32_i32_dpp v89, v221 row_ror:8 row_mask:0xf bank_mask:0xc
v_cvt_f32_i32_dpp v90, v222 row_ror:8 row_mask:0xf bank_mask:0xc
v_cvt_f32_i32_dpp v91, v223 row_ror:8 row_mask:0xf bank_mask:0xc
v_cvt_f32_i32_dpp v92, v216 row_ror:8 row_mask:0xf bank_mask:0x3
v_cvt_f32_i32_dpp v93, v217 row_ror:8 row_mask:0xf bank_mask:0x3
v_cvt_f32_i32_dpp v94, v218 row_ror:8 row_mask:0xf bank_mask:0x3
v_cvt_f32_i32_dpp v95, v219 row_ror:8 row_mask:0xf bank_mask:0x3
v_cvt_pk_bf16_f32 v96, v88, v89
v_cvt_pk_bf16_f32 v97, v90, v91
v_cvt_pk_bf16_f32 v98, v92, v93
v_cvt_pk_bf16_f32 v99, v94, v95
s_nop 1
v_mfma_f32_16x16x32_bf16 v[36:39], v[96:99], v[16:19], v[36:39]
s_waitcnt vmcnt(32)
v_cvt_f32_i32 v88, v224
v_cvt_f32_i32 v89, v225
v_cvt_f32_i32 v90, v226
v_cvt_f32_i32 v91, v227
v_cvt_f32_i32 v92, v228
v_cvt_f32_i32 v93, v229
v_cvt_f32_i32 v94, v230
v_cvt_f32_i32 v95, v231
v_cvt_f32_i32_dpp v88, v228 row_ror:8 row_mask:0xf bank_mask:0xc
v_cvt_f32_i32_dpp v89, v229 row_ror:8 row_mask:0xf bank_mask:0xc
v_cvt_f32_i32_dpp v90, v230 row_ror:8 row_mask:0xf bank_mask:0xc
v_cvt_f32_i32_dpp v91, v231 row_ror:8 row_mask:0xf bank_mask:0xc
v_cvt_f32_i32_dpp v92, v224 row_ror:8 row_mask:0xf bank_mask:0x3
v_cvt_f32_i32_dpp v93, v225 row_ror:8 row_mask:0xf bank_mask:0x3
v_cvt_f32_i32_dpp v94, v226 row_ror:8 row_mask:0xf bank_mask:0x3
v_cvt_f32_i32_dpp v95, v227 row_ror:8 row_mask:0xf bank_mask:0x3
v_cvt_pk_bf16_f32 v96, v88, v89
v_cvt_pk_bf16_f32 v97, v90, v91
v_cvt_pk_bf16_f32 v98, v92, v93
v_cvt_pk_bf16_f32 v99, v94, v95
s_nop 1
v_mfma_f32_16x16x32_bf16 v[36:39], v[96:99], v[20:23], v[36:39]
s_nop 7
v_add_f32_dpp v24, v24, v24 row_ror:4 row_mask:0xf bank_mask:0xf
v_add_f32_dpp v25, v25, v25 row_ror:4 row_mask:0xf bank_mask:0xf
v_add_f32_dpp v26, v26, v26 row_ror:4 row_mask:0xf bank_mask:0xf
v_add_f32_dpp v27, v27, v27 row_ror:4 row_mask:0xf bank_mask:0xf
v_add_f32_dpp v28, v28, v28 row_ror:4 row_mask:0xf bank_mask:0xf
v_add_f32_dpp v29, v29, v29 row_ror:4 row_mask:0xf bank_mask:0xf
v_add_f32_dpp v30, v30, v30 row_ror:4 row_mask:0xf bank_mask:0xf
v_add_f32_dpp v31, v31, v31 row_ror:4 row_mask:0xf bank_mask:0xf
v_add_f32_dpp v32, v32, v32 row_ror:4 row_mask:0xf bank_mask:0xf
v_add_f32_dpp v33, v33, v33 row_ror:4 row_mask:0xf bank_mask:0xf
v_add_f32_dpp v34, v34, v34 row_ror:4 row_mask:0xf bank_mask:0xf
v_add_f32_dpp v35, v35, v35 row_ror:4 row_mask:0xf bank_mask:0xf
v_add_f32_dpp v36, v36, v36 row_ror:4 row_mask:0xf bank_mask:0xf
v_add_f32_dpp v37, v37, v37 row_ror:4 row_mask:0xf bank_mask:0xf
v_add_f32_dpp v38, v38, v38 row_ror:4 row_mask:0xf bank_mask:0xf
v_add_f32_dpp v39, v39, v39 row_ror:4 row_mask:0xf bank_mask:0xf
v_max3_f32 v3, v24, v25, v26
v_max3_f32 v4, v27, v28, v29
v_max3_f32 v3, v3, v30, v31
v_max3_f32 v4, v4, v32, v33
v_max3_f32 v3, v3, v34, v35
v_max3_f32 v4, v4, v36, v37
v_max3_f32 v3, v3, v38, v39
v_max_f32 v3, v3, v4
v_mov_b32 v4, v3
s_nop 1
v_permlane16_swap_b32 v4, v3
v_max_f32 v3, v3, v4
v_mov_b32 v4, v3
s_nop 1
v_permlane32_swap_b32 v4, v3
v_max_f32 v3, v3, v4
v_and_b32 v90, 3, v0
v_lshlrev_b32 v89, 5, v90
s_lshl_b32 s70, s3, 2
v_add_u32 v89, s70, v89
v_lshlrev_b32 v90, 2, v90
s_mov_b64 exec, 15
ds_write_b32 v89, v3 offset:0
ds_write_b32 v90, v6 offset:256
s_mov_b64 exec, -1
v_mov_b32 v6, v89
v_xor_b32 v80, s75, v80
v_xor_b32 v81, s75, v81
v_xor_b32 v82, s75, v82
v_xor_b32 v83, s75, v83
v_xor_b32 v84, s75, v84
v_xor_b32 v85, s75, v85
v_xor_b32 v86, s75, v86
v_xor_b32 v87, s75, v87
v_mul_f32 v3, s65, v3
v_fma_f32 v24, v24, s65, -v3
v_fma_f32 v25, v25, s65, -v3
v_fma_f32 v26, v26, s65, -v3
v_fma_f32 v27, v27, s65, -v3
v_exp_f32 v24, v24
v_exp_f32 v25, v25
v_exp_f32 v26, v26
v_exp_f32 v27, v27
v_lshlrev_b32 v88, 16, v72
v_and_b32 v89, s64, v72
v_lshlrev_b32 v90, 16, v73
v_and_b32 v91, s64, v73
v_mov_b32 v7, v24
v_add_f32 v7, v7, v25
v_add_f32 v7, v7, v26
v_add_f32 v7, v7, v27
v_mul_f32 v24, v24, v88
v_mul_f32 v25, v25, v89
v_mul_f32 v26, v26, v90
v_mul_f32 v27, v27, v91
v_and_b32 v92, v5, v24
v_and_b32 v93, v5, v25
v_and_b32 v94, v5, v26
v_and_b32 v95, v5, v27
v_sub_f32 v24, v24, v92
v_sub_f32 v25, v25, v93
v_sub_f32 v26, v26, v94
v_sub_f32 v27, v27, v95
v_perm_b32 v8, v25, v24, s66
v_perm_b32 v9, v27, v26, s66
v_fma_f32 v28, v28, s65, -v3
v_fma_f32 v29, v29, s65, -v3
v_fma_f32 v30, v30, s65, -v3
v_fma_f32 v31, v31, s65, -v3
v_exp_f32 v28, v28
v_exp_f32 v29, v29
v_exp_f32 v30, v30
v_exp_f32 v31, v31
v_lshlrev_b32 v88, 16, v74
v_and_b32 v89, s64, v74
v_lshlrev_b32 v90, 16, v75
v_and_b32 v91, s64, v75
v_add_f32 v7, v7, v28
v_add_f32 v7, v7, v29
v_add_f32 v7, v7, v30
v_add_f32 v7, v7, v31
v_mul_f32 v28, v28, v88
v_mul_f32 v29, v29, v89
v_mul_f32 v30, v30, v90
v_mul_f32 v31, v31, v91
v_and_b32 v92, v5, v28
v_and_b32 v93, v5, v29
v_and_b32 v94, v5, v30
v_and_b32 v95, v5, v31
v_sub_f32 v28, v28, v92
v_sub_f32 v29, v29, v93
v_sub_f32 v30, v30, v94
v_sub_f32 v31, v31, v95
v_perm_b32 v10, v29, v28, s66
v_perm_b32 v11, v31, v30, s66
v_fma_f32 v32, v32, s65, -v3
v_fma_f32 v33, v33, s65, -v3
v_fma_f32 v34, v34, s65, -v3
v_fma_f32 v35, v35, s65, -v3
v_exp_f32 v32, v32
v_exp_f32 v33, v33
v_exp_f32 v34, v34
v_exp_f32 v35, v35
v_lshlrev_b32 v88, 16, v76
v_and_b32 v89, s64, v76
v_lshlrev_b32 v90, 16, v77
v_and_b32 v91, s64, v77
v_add_f32 v7, v7, v32
v_add_f32 v7, v7, v33
v_add_f32 v7, v7, v34
v_add_f32 v7, v7, v35
v_mul_f32 v32, v32, v88
v_mul_f32 v33, v33, v89
v_mul_f32 v34, v34, v90
v_mul_f32 v35, v35, v91
v_and_b32 v92, v5, v32
v_and_b32 v93, v5, v33
v_and_b32 v94, v5, v34
v_and_b32 v95, v5, v35
v_sub_f32 v32, v32, v92
v_sub_f32 v33, v33, v93
v_sub_f32 v34, v34, v94
v_sub_f32 v35, v35, v95
v_perm_b32 v12, v33, v32, s66
v_perm_b32 v13, v35, v34, s66
v_fma_f32 v36, v36, s65, -v3
v_fma_f32 v37, v37, s65, -v3
v_fma_f32 v38, v38, s65, -v3
v_fma_f32 v39, v39, s65, -v3
v_exp_f32 v36, v36
v_exp_f32 v37, v37
v_exp_f32 v38, v38
v_exp_f32 v39, v39
v_lshlrev_b32 v88, 16, v78
v_and_b32 v89, s64, v78
v_lshlrev_b32 v90, 16, v79
v_and_b32 v91, s64, v79
v_add_f32 v7, v7, v36
v_add_f32 v7, v7, v37
v_add_f32 v7, v7, v38
v_add_f32 v7, v7, v39
v_mul_f32 v36, v36, v88
v_mul_f32 v37, v37, v89
v_mul_f32 v38, v38, v90
v_mul_f32 v39, v39, v91
v_and_b32 v92, v5, v36
v_and_b32 v93, v5, v37
v_and_b32 v94, v5, v38
v_and_b32 v95, v5, v39
v_sub_f32 v36, v36, v92
v_sub_f32 v37, v37, v93
v_sub_f32 v38, v38, v94
v_sub_f32 v39, v39, v95
v_perm_b32 v14, v37, v36, s66
v_perm_b32 v15, v39, v38, s66
v_mov_b32 v4, v7
s_nop 1
v_permlane16_swap_b32 v4, v7
v_add_f32 v7, v7, v4
v_mov_b32 v4, v7
s_nop 1
v_permlane32_swap_b32 v4, v7
v_add_f32 v7, v7, v4
v_mfma_f32_16x16x32_bf16 v[100:103], v[8:11], v[80:83], 0
v_mfma_f32_16x16x32_bf16 v[100:103], v[12:15], v[84:87], v[100:103]
s_mov_b64 exec, 15
ds_write_b32 v6, v7 offset:128
s_mov_b64 exec, -1
v_lshrrev_b32 v3, 4, v0
v_and_b32 v4, 15, v0
v_lshlrev_b32 v3, 9, v3
v_lshl_add_u32 v3, v4, 4, v3
s_lshl_b32 s70, s3, 11
v_add_u32 v3, s70, v3
s_waitcnt vmcnt(30)
v_cvt_f32_i32 v88, v232
v_cvt_f32_i32 v89, v233
v_cvt_f32_i32 v90, v234
v_cvt_f32_i32 v91, v235
v_cvt_f32_i32 v92, v236
v_cvt_f32_i32 v93, v237
v_cvt_f32_i32 v94, v238
v_cvt_f32_i32 v95, v239
v_cvt_pk_bf16_f32 v24, v88, v92
v_cvt_pk_bf16_f32 v28, v89, v93
v_cvt_pk_bf16_f32 v32, v90, v94
v_cvt_pk_bf16_f32 v36, v91, v95
s_waitcnt vmcnt(28)
v_cvt_f32_i32 v88, v240
v_cvt_f32_i32 v89, v241
v_cvt_f32_i32 v90, v242
v_cvt_f32_i32 v91, v243
v_cvt_f32_i32 v92, v244
v_cvt_f32_i32 v93, v245
v_cvt_f32_i32 v94, v246
v_cvt_f32_i32 v95, v247
v_cvt_pk_bf16_f32 v25, v88, v92
v_cvt_pk_bf16_f32 v29, v89, v93
v_cvt_pk_bf16_f32 v33, v90, v94
v_cvt_pk_bf16_f32 v37, v91, v95
s_waitcnt vmcnt(26)
v_cvt_f32_i32 v88, v248
v_cvt_f32_i32 v89, v249
v_cvt_f32_i32 v90, v250
v_cvt_f32_i32 v91, v251
v_cvt_f32_i32 v92, v252
v_cvt_f32_i32 v93, v253
v_cvt_f32_i32 v94, v254
v_cvt_f32_i32 v95, v255
v_cvt_pk_bf16_f32 v26, v88, v92
v_cvt_pk_bf16_f32 v30, v89, v93
v_cvt_pk_bf16_f32 v34, v90, v94
v_cvt_pk_bf16_f32 v38, v91, v95
s_waitcnt vmcnt(24)
v_cvt_f32_i32 v88, v104
v_cvt_f32_i32 v89, v105
v_cvt_f32_i32 v90, v106
v_cvt_f32_i32 v91, v107
v_cvt_f32_i32 v92, v108
v_cvt_f32_i32 v93, v109
v_cvt_f32_i32 v94, v110
v_cvt_f32_i32 v95, v111
v_cvt_pk_bf16_f32 v27, v88, v92
v_cvt_pk_bf16_f32 v31, v89, v93
v_cvt_pk_bf16_f32 v35, v90, v94
v_cvt_pk_bf16_f32 v39, v91, v95
s_nop 0
v_mfma_f32_16x16x32_bf16 v[40:43], v[8:11], v[24:27], v[100:103]
v_mfma_f32_16x16x32_bf16 v[44:47], v[8:11], v[28:31], v[100:103]
v_mfma_f32_16x16x32_bf16 v[48:51], v[8:11], v[32:35], v[100:103]
v_mfma_f32_16x16x32_bf16 v[52:55], v[8:11], v[36:39], v[100:103]
s_waitcnt vmcnt(22)
v_cvt_f32_i32 v88, v112
v_cvt_f32_i32 v89, v113
v_cvt_f32_i32 v90, v114
v_cvt_f32_i32 v91, v115
v_cvt_f32_i32 v92, v116
v_cvt_f32_i32 v93, v117
v_cvt_f32_i32 v94, v118
v_cvt_f32_i32 v95, v119
v_cvt_pk_bf16_f32 v24, v88, v92
v_cvt_pk_bf16_f32 v28, v89, v93
v_cvt_pk_bf16_f32 v32, v90, v94
v_cvt_pk_bf16_f32 v36, v91, v95
s_waitcnt vmcnt(20)
v_cvt_f32_i32 v88, v120
v_cvt_f32_i32 v89, v121
v_cvt_f32_i32 v90, v122
v_cvt_f32_i32 v91, v123
v_cvt_f32_i32 v92, v124
v_cvt_f32_i32 v93, v125
v_cvt_f32_i32 v94, v126
v_cvt_f32_i32 v95, v127
v_cvt_pk_bf16_f32 v25, v88, v92
v_cvt_pk_bf16_f32 v29, v89, v93
v_cvt_pk_bf16_f32 v33, v90, v94
v_cvt_pk_bf16_f32 v37, v91, v95
s_waitcnt vmcnt(18)
v_cvt_f32_i32 v88, v128
v_cvt_f32_i32 v89, v129
v_cvt_f32_i32 v90, v130
v_cvt_f32_i32 v91, v131
v_cvt_f32_i32 v92, v132
v_cvt_f32_i32 v93, v133
v_cvt_f32_i32 v94, v134
v_cvt_f32_i32 v95, v135
v_cvt_pk_bf16_f32 v26, v88, v92
v_cvt_pk_bf16_f32 v30, v89, v93
v_cvt_pk_bf16_f32 v34, v90, v94
v_cvt_pk_bf16_f32 v38, v91, v95
s_waitcnt vmcnt(16)
v_cvt_f32_i32 v88, v136
v_cvt_f32_i32 v89, v137
v_cvt_f32_i32 v90, v138
v_cvt_f32_i32 v91, v139
v_cvt_f32_i32 v92, v140
v_cvt_f32_i32 v93, v141
v_cvt_f32_i32 v94, v142
v_cvt_f32_i32 v95, v143
v_cvt_pk_bf16_f32 v27, v88, v92
v_cvt_pk_bf16_f32 v31, v89, v93
v_cvt_pk_bf16_f32 v35, v90, v94
v_cvt_pk_bf16_f32 v39, v91, v95
s_nop 0
v_mfma_f32_16x16x32_bf16 v[56:59], v[8:11], v[24:27], v[100:103]
v_mfma_f32_16x16x32_bf16 v[60:63], v[8:11], v[28:31], v[100:103]
v_mfma_f32_16x16x32_bf16 v[64:67], v[8:11], v[32:35], v[100:103]
v_mfma_f32_16x16x32_bf16 v[68:71], v[8:11], v[36:39], v[100:103]
s_waitcnt vmcnt(14)
v_cvt_f32_i32 v88, v144
v_cvt_f32_i32 v89, v145
v_cvt_f32_i32 v90, v146
v_cvt_f32_i32 v91, v147
v_cvt_f32_i32 v92, v148
v_cvt_f32_i32 v93, v149
v_cvt_f32_i32 v94, v150
v_cvt_f32_i32 v95, v151
v_cvt_pk_bf16_f32 v24, v88, v92
v_cvt_pk_bf16_f32 v28, v89, v93
v_cvt_pk_bf16_f32 v32, v90, v94
v_cvt_pk_bf16_f32 v36, v91, v95
s_waitcnt vmcnt(12)
v_cvt_f32_i32 v88, v152
v_cvt_f32_i32 v89, v153
v_cvt_f32_i32 v90, v154
v_cvt_f32_i32 v91, v155
v_cvt_f32_i32 v92, v156
v_cvt_f32_i32 v93, v157
v_cvt_f32_i32 v94, v158
v_cvt_f32_i32 v95, v159
v_cvt_pk_bf16_f32 v25, v88, v92
v_cvt_pk_bf16_f32 v29, v89, v93
v_cvt_pk_bf16_f32 v33, v90, v94
v_cvt_pk_bf16_f32 v37, v91, v95
s_waitcnt vmcnt(10)
v_cvt_f32_i32 v88, v160
v_cvt_f32_i32 v89, v161
v_cvt_f32_i32 v90, v162
v_cvt_f32_i32 v91, v163
v_cvt_f32_i32 v92, v164
v_cvt_f32_i32 v93, v165
v_cvt_f32_i32 v94, v166
v_cvt_f32_i32 v95, v167
v_cvt_pk_bf16_f32 v26, v88, v92
v_cvt_pk_bf16_f32 v30, v89, v93
v_cvt_pk_bf16_f32 v34, v90, v94
v_cvt_pk_bf16_f32 v38, v91, v95
s_waitcnt vmcnt(8)
v_cvt_f32_i32 v88, v168
v_cvt_f32_i32 v89, v169
v_cvt_f32_i32 v90, v170
v_cvt_f32_i32 v91, v171
v_cvt_f32_i32 v92, v172
v_cvt_f32_i32 v93, v173
v_cvt_f32_i32 v94, v174
v_cvt_f32_i32 v95, v175
v_cvt_pk_bf16_f32 v27, v88, v92
v_cvt_pk_bf16_f32 v31, v89, v93
v_cvt_pk_bf16_f32 v35, v90, v94
v_cvt_pk_bf16_f32 v39, v91, v95
s_nop 0
v_mfma_f32_16x16x32_bf16 v[40:43], v[12:15], v[24:27], v[40:43]
v_mfma_f32_16x16x32_bf16 v[44:47], v[12:15], v[28:31], v[44:47]
v_mfma_f32_16x16x32_bf16 v[48:51], v[12:15], v[32:35], v[48:51]
v_mfma_f32_16x16x32_bf16 v[52:55], v[12:15], v[36:39], v[52:55]
s_nop 4
v_permlane16_swap_b32 v40, v41
v_permlane16_swap_b32 v42, v43
v_permlane16_swap_b32 v44, v45
v_permlane16_swap_b32 v46, v47
v_permlane16_swap_b32 v48, v49
v_permlane16_swap_b32 v50, v51
v_permlane16_swap_b32 v52, v53
v_permlane16_swap_b32 v54, v55
v_add_f32 v88, v40, v41
v_add_f32 v92, v42, v43
v_add_f32 v89, v44, v45
v_add_f32 v93, v46, v47
v_add_f32 v90, v48, v49
v_add_f32 v94, v50, v51
v_add_f32 v91, v52, v53
v_add_f32 v95, v54, v55
s_nop 0
v_permlane32_swap_b32 v88, v92
v_permlane32_swap_b32 v89, v93
v_permlane32_swap_b32 v90, v94
v_permlane32_swap_b32 v91, v95
ds_write_b128 v3, v[88:91] offset:512
s_nop 1
s_waitcnt vmcnt(6)
v_cvt_f32_i32 v88, v176
v_cvt_f32_i32 v89, v177
v_cvt_f32_i32 v90, v178
v_cvt_f32_i32 v91, v179
v_cvt_f32_i32 v92, v180
v_cvt_f32_i32 v93, v181
v_cvt_f32_i32 v94, v182
v_cvt_f32_i32 v95, v183
v_cvt_pk_bf16_f32 v24, v88, v92
v_cvt_pk_bf16_f32 v28, v89, v93
v_cvt_pk_bf16_f32 v32, v90, v94
v_cvt_pk_bf16_f32 v36, v91, v95
s_waitcnt vmcnt(4)
v_cvt_f32_i32 v88, v184
v_cvt_f32_i32 v89, v185
v_cvt_f32_i32 v90, v186
v_cvt_f32_i32 v91, v187
v_cvt_f32_i32 v92, v188
v_cvt_f32_i32 v93, v189
v_cvt_f32_i32 v94, v190
v_cvt_f32_i32 v95, v191
v_cvt_pk_bf16_f32 v25, v88, v92
v_cvt_pk_bf16_f32 v29, v89, v93
v_cvt_pk_bf16_f32 v33, v90, v94
v_cvt_pk_bf16_f32 v37, v91, v95
s_waitcnt vmcnt(2)
v_cvt_f32_i32 v88, v192
v_cvt_f32_i32 v89, v193
v_cvt_f32_i32 v90, v194
v_cvt_f32_i32 v91, v195
v_cvt_f32_i32 v92, v196
v_cvt_f32_i32 v93, v197
v_cvt_f32_i32 v94, v198
v_cvt_f32_i32 v95, v199
v_cvt_pk_bf16_f32 v26, v88, v92
v_cvt_pk_bf16_f32 v30, v89, v93
v_cvt_pk_bf16_f32 v34, v90, v94
v_cvt_pk_bf16_f32 v38, v91, v95
s_waitcnt vmcnt(0)
v_cvt_f32_i32 v88, v200
v_cvt_f32_i32 v89, v201
v_cvt_f32_i32 v90, v202
v_cvt_f32_i32 v91, v203
v_cvt_f32_i32 v92, v204
v_cvt_f32_i32 v93, v205
v_cvt_f32_i32 v94, v206
v_cvt_f32_i32 v95, v207
v_cvt_pk_bf16_f32 v27, v88, v92
v_cvt_pk_bf16_f32 v31, v89, v93
v_cvt_pk_bf16_f32 v35, v90, v94
v_cvt_pk_bf16_f32 v39, v91, v95
s_nop 0
v_mfma_f32_16x16x32_bf16 v[56:59], v[12:15], v[24:27], v[56:59]
v_mfma_f32_16x16x32_bf16 v[60:63], v[12:15], v[28:31], v[60:63]
v_mfma_f32_16x16x32_bf16 v[64:67], v[12:15], v[32:35], v[64:67]
v_mfma_f32_16x16x32_bf16 v[68:71], v[12:15], v[36:39], v[68:71]
s_nop 4
v_permlane16_swap_b32 v56, v57
v_permlane16_swap_b32 v58, v59
v_permlane16_swap_b32 v60, v61
v_permlane16_swap_b32 v62, v63
v_permlane16_swap_b32 v64, v65
v_permlane16_swap_b32 v66, v67
v_permlane16_swap_b32 v68, v69
v_permlane16_swap_b32 v70, v71
v_add_f32 v88, v56, v57
v_add_f32 v92, v58, v59
v_add_f32 v89, v60, v61
v_add_f32 v93, v62, v63
v_add_f32 v90, v64, v65
v_add_f32 v94, v66, v67
v_add_f32 v91, v68, v69
v_add_f32 v95, v70, v71
s_nop 0
v_permlane32_swap_b32 v88, v92
v_permlane32_swap_b32 v89, v93
v_permlane32_swap_b32 v90, v94
v_permlane32_swap_b32 v91, v95
ds_write_b128 v3, v[88:91] offset:768
s_cmp_ge_u32 s3, 4
s_cbranch_scc1 L_idle
buffer_load_dwordx3 v[208:210], off, s[60:63], 0 sc1
s_waitcnt vmcnt(0)
v_readfirstlane_b32 s70, v208
v_readfirstlane_b32 s71, v209
s_cmp_ge_u32 s76, 4
s_cselect_b32 s70, s71, s70
s_and_b32 s71, s76, 3
s_lshl_b32 s71, s71, 3
s_lshr_b32 s70, s70, s71
s_and_b32 s70, s70, 0xff
s_cmp_eq_u32 s70, 32
s_cselect_b32 s77, 1, 0
s_cmp_ge_u32 s76, 8
s_cselect_b32 s77, 0, s77
s_cmp_eq_u32 s3, 2
s_cbranch_scc1 L_stats
s_cmp_eq_u32 s3, 3
s_cbranch_scc1 L_cons
s_lshl_b32 s70, s3, 6
v_add_u32 v1, s70, v0
v_lshrrev_b32 v5, 5, v1
v_lshlrev_b32 v5, 5, v5
v_lshlrev_b32 v2, 4, v1
v_lshrrev_b32 v6, 2, v1
v_and_b32 v4, 3, v1
v_lshlrev_b32 v6, 11, v6
v_lshl_add_u32 v4, v4, 4, v6
s_waitcnt lgkmcnt(0)
s_barrier
ds_read_b128 v[8:11], v5 offset:0
ds_read_b128 v[12:15], v5 offset:16
ds_read_b128 v[16:19], v2 offset:512
ds_read_b128 v[20:23], v2 offset:2560
ds_read_b128 v[24:27], v2 offset:4608
ds_read_b128 v[28:31], v2 offset:6656
ds_read_b128 v[32:35], v2 offset:8704
ds_read_b128 v[36:39], v2 offset:10752
ds_read_b128 v[40:43], v2 offset:12800
ds_read_b128 v[44:47], v2 offset:14848
s_waitcnt lgkmcnt(8)
v_max3_f32 v6, v8, v9, v10
v_max3_f32 v7, v11, v12, v13
v_max3_f32 v6, v6, v14, v15
v_max_f32 v6, v6, v7
v_mul_f32 v6, s65, v6
v_fma_f32 v8, v8, s65, -v6
v_fma_f32 v9, v9, s65, -v6
v_fma_f32 v10, v10, s65, -v6
v_fma_f32 v11, v11, s65, -v6
v_fma_f32 v12, v12, s65, -v6
v_fma_f32 v13, v13, s65, -v6
v_fma_f32 v14, v14, s65, -v6
v_fma_f32 v15, v15, s65, -v6
v_exp_f32 v8, v8
v_exp_f32 v9, v9
v_exp_f32 v10, v10
v_exp_f32 v11, v11
v_exp_f32 v12, v12
v_exp_f32 v13, v13
v_exp_f32 v14, v14
v_exp_f32 v15, v15
s_waitcnt lgkmcnt(7)
v_mul_f32 v16, v16, v8
v_mul_f32 v17, v17, v8
v_mul_f32 v18, v18, v8
v_mul_f32 v19, v19, v8
s_waitcnt lgkmcnt(6)
v_fmac_f32 v16, v20, v9
v_fmac_f32 v17, v21, v9
v_fmac_f32 v18, v22, v9
v_fmac_f32 v19, v23, v9
s_waitcnt lgkmcnt(5)
v_fmac_f32 v16, v24, v10
v_fmac_f32 v17, v25, v10
v_fmac_f32 v18, v26, v10
v_fmac_f32 v19, v27, v10
s_waitcnt lgkmcnt(4)
v_fmac_f32 v16, v28, v11
v_fmac_f32 v17, v29, v11
v_fmac_f32 v18, v30, v11
v_fmac_f32 v19, v31, v11
s_waitcnt lgkmcnt(3)
v_fmac_f32 v16, v32, v12
v_fmac_f32 v17, v33, v12
v_fmac_f32 v18, v34, v12
v_fmac_f32 v19, v35, v12
s_waitcnt lgkmcnt(2)
v_fmac_f32 v16, v36, v13
v_fmac_f32 v17, v37, v13
v_fmac_f32 v18, v38, v13
v_fmac_f32 v19, v39, v13
s_waitcnt lgkmcnt(1)
v_fmac_f32 v16, v40, v14
v_fmac_f32 v17, v41, v14
v_fmac_f32 v18, v42, v14
v_fmac_f32 v19, v43, v14
s_waitcnt lgkmcnt(0)
v_fmac_f32 v16, v44, v15
v_fmac_f32 v17, v45, v15
v_fmac_f32 v18, v46, v15
v_fmac_f32 v19, v47, v15
v_min_u32 v16, -2, v16
v_min_u32 v17, -2, v17
v_min_u32 v18, -2, v18
v_min_u32 v19, -2, v19
s_cmp_eq_u32 s77, 1
s_cbranch_scc1 L_po_f
buffer_store_dwordx4 v[16:19], v4, s[52:55], 0 offen offset:0 sc1
s_branch L_po_d
L_po_f:
buffer_store_dwordx4 v[16:19], v4, s[52:55], 0 offen offset:0
L_po_d:
s_endpgm
L_stats:
v_and_b32 v1, 3, v0
v_lshlrev_b32 v4, 8, v1
v_lshlrev_b32 v2, 5, v1
v_lshlrev_b32 v3, 2, v1
s_waitcnt lgkmcnt(0)
s_barrier
ds_read_b128 v[24:27], v2 offset:0
ds_read_b128 v[28:31], v2 offset:16
ds_read_b128 v[16:19], v2 offset:128
ds_read_b128 v[20:23], v2 offset:144
ds_read_b32 v32, v3 offset:256
s_waitcnt lgkmcnt(3)
v_max3_f32 v6, v24, v25, v26
v_max3_f32 v7, v27, v28, v29
v_max3_f32 v6, v6, v30, v31
v_max_f32 v6, v6, v7
v_mul_f32 v7, s65, v6
v_fma_f32 v24, v24, s65, -v7
v_fma_f32 v25, v25, s65, -v7
v_fma_f32 v26, v26, s65, -v7
v_fma_f32 v27, v27, s65, -v7
v_fma_f32 v28, v28, s65, -v7
v_fma_f32 v29, v29, s65, -v7
v_fma_f32 v30, v30, s65, -v7
v_fma_f32 v31, v31, s65, -v7
v_exp_f32 v24, v24
v_exp_f32 v25, v25
v_exp_f32 v26, v26
v_exp_f32 v27, v27
v_exp_f32 v28, v28
v_exp_f32 v29, v29
v_exp_f32 v30, v30
v_exp_f32 v31, v31
s_waitcnt lgkmcnt(0)
v_sub_f32 v6, v6, v32
v_mul_f32 v16, v16, v24
v_mul_f32 v18, v18, v26
v_fmac_f32 v16, v17, v25
v_fmac_f32 v18, v19, v27
v_fmac_f32 v16, v20, v28
v_fmac_f32 v18, v21, v29
v_fmac_f32 v16, v22, v30
v_fmac_f32 v18, v23, v31
v_mul_f32 v17, s65, v6
v_add_f32 v16, v16, v18
v_min_u32 v17, -2, v17
v_min_u32 v16, -2, v16
s_mov_b64 exec, 15
s_cmp_eq_u32 s77, 1
s_cbranch_scc1 L_ps_f
buffer_store_dwordx2 v[16:17], v4, s[96:99], 0 offen offset:0 sc1
s_branch L_ps_d
L_ps_f:
buffer_store_dwordx2 v[16:17], v4, s[96:99], 0 offen offset:0
L_ps_d:
s_endpgm
L_cons:
s_lshl_b32 s70, s2, 11
s_add_u32 s52, s22, s70
s_addc_u32 s53, s23, 0
s_mov_b32 s54, 2048
s_mov_b32 s55, 0x20000
s_lshr_b32 s70, s2, 3
s_lshl_b32 s70, s70, 8
s_add_u32 s70, s70, 1048576
s_add_u32 s96, s22, s70
s_addc_u32 s97, s23, 0
s_mov_b32 s98, 256
s_mov_b32 s99, 0x20000
s_lshl_b32 s70, s2, 5
s_add_u32 s56, s18, s70
s_addc_u32 s57, s19, 0
s_mov_b32 s58, 32
s_mov_b32 s59, 0x20000
v_lshrrev_b32 v8, 2, v0
v_and_b32 v9, 3, v0
v_lshlrev_b32 v10, 3, v8
v_lshlrev_b32 v11, 4, v0
v_lshrrev_b32 v12, 4, v0
v_and_b32 v13, 1, v12
v_lshrrev_b32 v12, 1, v12
v_lshl_or_b32 v12, v13, 1, v12
v_lshl_add_u32 v12, v9, 2, v12
v_lshlrev_b32 v12, 1, v12
s_mov_b32 s72, 0x40000
s_waitcnt vmcnt(0)
L_c_rdy:
v_sad_u8 v13, v208, 0, 0
v_sad_u8 v13, v209, 0, v13
v_sad_u8 v13, v210, 0, v13
v_cmp_gt_u32 vcc, 32, v13
s_cbranch_vccz L_c_rdyok
s_sub_u32 s72, s72, 1
s_cbranch_scc1 L_c_rdyok
buffer_load_dwordx3 v[208:210], off, s[60:63], 0 sc1
s_waitcnt vmcnt(0)
s_branch L_c_rdy
L_c_rdyok:
s_waitcnt lgkmcnt(0)
s_barrier
L_c_poll:
buffer_load_dwordx2 v[24:25], v10, s[96:99], 0 offen sc1
buffer_load_dwordx2 v[26:27], v10, s[96:99], 0 offen offset:128 sc1
buffer_load_dwordx4 v[16:19], v11, s[52:55], 0 offen sc1
buffer_load_dwordx4 v[20:23], v11, s[52:55], 0 offen offset:1024 sc1
s_waitcnt vmcnt(0)
v_max3_u32 v30, v16, v17, v18
v_max3_u32 v31, v19, v20, v21
v_max3_u32 v30, v30, v22, v23
v_max3_u32 v31, v31, v24, v25
v_max3_u32 v30, v30, v26, v27
v_max_u32 v30, v30, v31
v_cmp_eq_u32 vcc, -1, v30
s_cbranch_vccz L_c_go
s_sub_u32 s72, s72, 1
s_cbranch_scc0 L_c_poll
L_c_go:
v_max_f32 v30, v25, v27
s_nop 1
v_max_f32_dpp v30, v30, v30 row_ror:4 row_mask:0xf bank_mask:0xf
s_nop 1
v_max_f32_dpp v30, v30, v30 row_ror:8 row_mask:0xf bank_mask:0xf
s_nop 0
v_mov_b32 v31, v30
s_nop 1
v_permlane16_swap_b32 v31, v30
v_max_f32 v30, v30, v31
v_mov_b32 v31, v30
s_nop 1
v_permlane32_swap_b32 v31, v30
v_max_f32 v30, v30, v31
v_sub_f32 v25, v25, v30
v_sub_f32 v27, v27, v30
v_exp_f32 v25, v25
v_exp_f32 v27, v27
s_nop 0
v_mul_f32 v24, v24, v25
v_mul_f32 v16, v16, v25
v_mul_f32 v17, v17, v25
v_mul_f32 v18, v18, v25
v_mul_f32 v19, v19, v25
v_fmac_f32 v24, v26, v27
v_fmac_f32 v16, v20, v27
v_fmac_f32 v17, v21, v27
v_fmac_f32 v18, v22, v27
v_fmac_f32 v19, v23, v27
v_add_f32_dpp v24, v24, v24 row_ror:4 row_mask:0xf bank_mask:0xf
s_nop 0
v_permlane32_swap_b32 v16, v17
v_permlane32_swap_b32 v18, v19
v_add_f32_dpp v24, v24, v24 row_ror:8 row_mask:0xf bank_mask:0xf
v_add_f32 v16, v16, v17
v_add_f32 v18, v18, v19
v_mov_b32 v30, v24
s_nop 1
v_permlane16_swap_b32 v16, v18
v_permlane16_swap_b32 v30, v24
v_add_f32 v16, v16, v18
v_add_f32 v24, v24, v30
s_nop 0
v_mov_b32 v30, v24
v_add_f32_dpp v16, v16, v16 row_ror:4 row_mask:0xf bank_mask:0xf
s_nop 0
v_permlane32_swap_b32 v30, v24
v_add_f32_dpp v16, v16, v16 row_ror:8 row_mask:0xf bank_mask:0xf
v_add_f32 v24, v24, v30
v_rcp_f32 v24, v24
s_nop 0
v_mul_f32 v16, v16, v24
v_cvt_pk_bf16_f32 v16, v16, v16
s_mov_b32 exec_lo, 0x000f000f
s_mov_b32 exec_hi, 0x000f000f
buffer_store_short v16, v12, s[56:59], 0 offen
s_endpgm
L_idle:
s_waitcnt lgkmcnt(0)
s_barrier
L_end:
s_endpgm
.section .rodata,"a"
.p2align 6
.amdhsa_kernel standalone__kv_cache_quant_int4_int2_kv_with_per_channel_or_per_token_scales__decode_kernel
  .amdhsa_next_free_vgpr 256
  .amdhsa_next_free_sgpr 100
  .amdhsa_accum_offset 256
  .amdhsa_group_segment_fixed_size 0
  .amdhsa_kernarg_size 80
  .amdhsa_user_sgpr_count 2
  .amdhsa_user_sgpr_kernarg_segment_ptr 1
  .amdhsa_system_sgpr_workgroup_id_x 1
.end_amdhsa_kernel
```
